```python
import torch

def _softmax(x, axis=-1):
    return torch.softmax(x, dim=axis)
def _gelu(x):
    return torch.nn.functional.gelu(x, approximate="tanh")
def _silu(x):
    return torch.nn.functional.silu(x)
def _sigmoid(x):
    return torch.sigmoid(x)
def _layernorm(x, axis=-1, eps=1e-5):
    m = x.mean(dim=axis, keepdim=True)
    v = x.var(dim=axis, keepdim=True, unbiased=False)
    return (x - m) / torch.sqrt(v + eps)
def _scatter_add(tgt, idx, src, axis=0):
    return tgt.clone().index_add_(axis, idx, src)
def _segment_sum(src, seg, n):
    out = torch.zeros((n,) + src.shape[1:], dtype=src.dtype)
    return out.index_add_(0, seg, src)
def _pad(x, pw):
    flat = tuple(v for pair in reversed(pw) for v in pair)
    return torch.nn.functional.pad(x, flat)

kernel_name = 'standalone__mha_softmax__sampling'

def setup_inputs():

    _w = (lambda a: (lambda t: t.to(torch.bfloat16) if t.is_floating_point() else t)(torch.as_tensor(a)))
    B, H, Sq, Sk, D = 8, 32, 4, 2048, 192
    return {
        "q": _w((lambda *s: torch.randn(*s, dtype=torch.bfloat16) * 0.8)(B, H, Sq, D)),
        "k": _w((lambda *s: torch.randn(*s, dtype=torch.bfloat16) * 0.8)(B, H, Sk, D)),
        "v": _w((lambda *s: torch.randn(*s, dtype=torch.bfloat16) * 0.05)(B, H, Sk, D)),
    }

def reference(q, k, v):
    scale = q.shape[-1] ** -0.5
    scores = torch.einsum("bhqd,bhkd->bhqk", q, k) * scale
    p = _softmax(scores, axis=-1)
    return torch.einsum("bhqk,bhkd->bhqd", p, v)
```

```asm
; @launch grid=(256,1,1) block=(256,1,1) lds=65664
.amdgcn_target "amdgcn-amd-amdhsa--gfx950"
.text
.globl standalone__mha_softmax__sampling_kernel
.p2align 8
.type standalone__mha_softmax__sampling_kernel,@function
standalone__mha_softmax__sampling_kernel:
    s_cmp_ge_u32 s2, 256
    s_cbranch_scc1 L_done
    s_load_dwordx8 s[4:11], s[0:1], 0
    s_mov_b32 s3, s2
    v_lshrrev_b32 v56, 6, v0
    v_and_b32 v0, 63, v0
    v_readfirstlane_b32 s28, v56
    v_mul_u32_u24 v56, 3072, v56
    v_bfe_u32 v57, v0, 2, 2
    v_mul_u32_u24 v57, 768, v57
    v_lshrrev_b32 v58, 4, v0
    v_lshlrev_b32 v58, 6, v58
    v_and_b32 v59, 3, v0
    v_lshlrev_b32 v60, 4, v59
    v_add3_u32 v1, v57, v58, v60
    v_add_u32 v1, v1, v56
    v_mul_u32_u24 v59, 384, v59
    v_lshrrev_b32 v58, 2, v0
    v_lshlrev_b32 v58, 4, v58
    v_add_u32 v61, v59, v58
    v_lshrrev_b32 v58, 5, v0
    v_mul_u32_u24 v58, 384, v58
    v_sub_u32 v55, v61, v58
    s_mul_i32 s38, s3, 786432
    s_mul_i32 s40, s3, 1536
    s_mov_b32 s14, 1536
    s_mov_b32 s15, 0x20000
    s_mov_b32 s18, 786432
    s_mov_b32 s19, 0x20000
    s_mul_i32 s39, s3, 56
    s_and_b32 s39, s39, 63
    s_mul_i32 s29, s39, 12288
    s_mov_b32 s30, s29
    v_add_u32 v55, 256, v55
    s_waitcnt lgkmcnt(0)
    s_add_u32 s12, s4, s40
    s_addc_u32 s13, s5, 0
    s_add_u32 s16, s6, s38
    s_addc_u32 s17, s7, 0
    buffer_load_dwordx4 v[8:11], v61, s[12:15], 0 offen
    buffer_load_dwordx4 v[128:131], v1, s[16:19], s29 offen offset:0 nt
    buffer_load_dwordx4 v[12:15], v55, s[12:15], 0 offen
    buffer_load_dwordx4 v[132:135], v1, s[16:19], s29 offen offset:256 nt
    buffer_load_dwordx4 v[20:23], v61, s[12:15], 0 offen offset:128
    buffer_load_dwordx4 v[136:139], v1, s[16:19], s29 offen offset:512 nt
    s_add_u32 s29, s29, 12288
    s_cmp_eq_u32 s29, 786432
    s_cselect_b32 s29, 0, s29
    buffer_load_dwordx4 v[140:143], v1, s[16:19], s29 offen offset:0 nt
    buffer_load_dwordx4 v[144:147], v1, s[16:19], s29 offen offset:256 nt
    buffer_load_dwordx4 v[148:151], v1, s[16:19], s29 offen offset:512 nt
    s_add_u32 s29, s29, 12288
    s_cmp_eq_u32 s29, 786432
    s_cselect_b32 s29, 0, s29
    s_mov_b32 s22, 786432
    s_mov_b32 s23, 0x20000
    s_mov_b32 s26, 1536
    s_mov_b32 s27, 0x20000
    s_add_u32 s20, s8, s38
    s_addc_u32 s21, s9, 0
    s_add_u32 s24, s10, s40
    s_addc_u32 s25, s11, 0
    v_lshrrev_b32 v57, 4, v0
    v_mul_u32_u24 v57, 768, v57
    v_and_b32 v58, 15, v0
    v_lshlrev_b32 v58, 4, v58
    v_add3_u32 v2, v57, v58, v56
    v_bfe_i32 v4, v0, 2, 1
    v_not_b32 v3, v4
    v_mov_b32 v5, 0xff800000
    v_mov_b32 v6, 0
    s_lshl_b32 s39, s28, 14
    v_lshlrev_b32 v7, 4, v0
    v_add_u32 v7, s39, v7
    v_mov_b32 v62, v7
    v_mov_b32 v63, v7
    s_mov_b32 s35, 0x3dd53b95
    s_mov_b32 s36, 0x05040100
    s_mov_b32 s37, 0x07060302
    v_mov_b32 v80, 0
    v_mov_b32 v81, 0
    v_mov_b32 v82, 0
    v_mov_b32 v83, 0
    v_mov_b32 v84, 0
    v_mov_b32 v85, 0
    v_mov_b32 v86, 0
    v_mov_b32 v87, 0
    v_mov_b32 v88, 0
    v_mov_b32 v89, 0
    v_mov_b32 v90, 0
    v_mov_b32 v91, 0
    v_mov_b32 v92, 0
    v_mov_b32 v93, 0
    v_mov_b32 v94, 0
    v_mov_b32 v95, 0
    v_mov_b32 v96, 0
    v_mov_b32 v97, 0
    v_mov_b32 v98, 0
    v_mov_b32 v99, 0
    v_mov_b32 v100, 0
    v_mov_b32 v101, 0
    v_mov_b32 v102, 0
    v_mov_b32 v103, 0
    v_mov_b32 v104, 0
    v_mov_b32 v105, 0
    v_mov_b32 v106, 0
    v_mov_b32 v107, 0
    v_mov_b32 v108, 0
    v_mov_b32 v109, 0
    v_mov_b32 v110, 0
    v_mov_b32 v111, 0
    v_mov_b32 v112, 0
    v_mov_b32 v113, 0
    v_mov_b32 v114, 0
    v_mov_b32 v115, 0
    v_mov_b32 v116, 0
    v_mov_b32 v117, 0
    v_mov_b32 v118, 0
    v_mov_b32 v119, 0
    v_mov_b32 v120, 0
    v_mov_b32 v121, 0
    v_mov_b32 v122, 0
    v_mov_b32 v123, 0
    v_mov_b32 v124, 0
    v_mov_b32 v125, 0
    v_mov_b32 v126, 0
    v_mov_b32 v127, 0
    v_ashrrev_i32 v57, 5, v0
    v_sub_u32 v57, 0, v57
    v_not_b32 v58, v57
    s_mov_b32 s34, 8
    s_waitcnt vmcnt(4)
    buffer_load_dwordx4 v[152:155], v1, s[16:19], s29 offen offset:0 nt
    s_waitcnt vmcnt(5)
    buffer_load_dwordx4 v[156:159], v1, s[16:19], s29 offen offset:256 nt
    s_waitcnt vmcnt(6)
    v_and_b32 v16, v12, v57
    v_and_b32 v17, v13, v57
    v_and_b32 v18, v14, v57
    v_and_b32 v19, v15, v57
    v_and_b32 v12, v12, v58
    v_and_b32 v13, v13, v58
    v_and_b32 v14, v14, v58
    v_and_b32 v15, v15, v58
    s_branch L_kmid
L_kloop:
    s_waitcnt vmcnt(4)
    buffer_load_dwordx4 v[128:131], v1, s[16:19], s29 offen offset:0 nt
    s_nop 3
    v_add_f32_dpp v29, v33, v32 row_shl:4 row_mask:0xf bank_mask:0x1
    s_nop 1
    v_add_f32_dpp v29, v34, v29 row_shl:8 row_mask:0xf bank_mask:0x1
    s_nop 1
    v_add_f32_dpp v29, v35, v29 row_shl:12 row_mask:0xf bank_mask:0x1
    s_waitcnt vmcnt(5)
    buffer_load_dwordx4 v[132:135], v1, s[16:19], s29 offen offset:256 nt
    v_add_f32_dpp v29, v36, v38 row_shr:8 row_mask:0xf bank_mask:0x4
    s_nop 1
    v_add_f32_dpp v29, v37, v29 row_shr:4 row_mask:0xf bank_mask:0x4
    s_nop 1
    v_add_f32_dpp v29, v39, v29 row_shl:4 row_mask:0xf bank_mask:0x4
    s_nop 1
    v_mov_b32_dpp v29, v29 row_shr:4 row_mask:0xf bank_mask:0xa
    s_waitcnt vmcnt(5)
    buffer_load_dwordx4 v[136:139], v1, s[16:19], s29 offen offset:512 nt
    s_add_u32 s29, s29, 12288
    s_cmp_eq_u32 s29, 786432
    s_cselect_b32 s29, 0, s29
    v_mfma_f32_16x16x32_bf16 v[32:35], v[200:203], v[8:11], 0
    v_mfma_f32_16x16x32_bf16 v[32:35], v[204:207], v[12:15], v[32:35]
    v_mfma_f32_16x16x32_bf16 v[36:39], v[204:207], v[16:19], 0
    v_mfma_f32_16x16x32_bf16 v[36:39], v[208:211], v[20:23], v[36:39]
    s_waitcnt vmcnt(4)
    buffer_load_dwordx4 v[140:143], v1, s[16:19], s29 offen offset:0 nt
    s_nop 3
    v_add_f32_dpp v30, v33, v32 row_shl:4 row_mask:0xf bank_mask:0x1
    s_nop 1
    v_add_f32_dpp v30, v34, v30 row_shl:8 row_mask:0xf bank_mask:0x1
    s_nop 1
    v_add_f32_dpp v30, v35, v30 row_shl:12 row_mask:0xf bank_mask:0x1
    s_waitcnt vmcnt(5)
    buffer_load_dwordx4 v[144:147], v1, s[16:19], s29 offen offset:256 nt
    v_add_f32_dpp v30, v36, v38 row_shr:8 row_mask:0xf bank_mask:0x4
    s_nop 1
    v_add_f32_dpp v30, v37, v30 row_shr:4 row_mask:0xf bank_mask:0x4
    s_nop 1
    v_add_f32_dpp v30, v39, v30 row_shl:4 row_mask:0xf bank_mask:0x4
    s_nop 1
    v_mov_b32_dpp v30, v30 row_shr:4 row_mask:0xf bank_mask:0xa
    s_waitcnt vmcnt(5)
    buffer_load_dwordx4 v[148:151], v1, s[16:19], s29 offen offset:512 nt
    s_add_u32 s29, s29, 12288
    s_cmp_eq_u32 s29, 786432
    s_cselect_b32 s29, 0, s29
    v_mfma_f32_16x16x32_bf16 v[32:35], v[212:215], v[8:11], 0
    v_mfma_f32_16x16x32_bf16 v[32:35], v[216:219], v[12:15], v[32:35]
    v_mfma_f32_16x16x32_bf16 v[36:39], v[216:219], v[16:19], 0
    v_mfma_f32_16x16x32_bf16 v[36:39], v[220:223], v[20:23], v[36:39]
    s_waitcnt vmcnt(4)
    buffer_load_dwordx4 v[152:155], v1, s[16:19], s29 offen offset:0 nt
    s_nop 3
    v_add_f32_dpp v31, v33, v32 row_shl:4 row_mask:0xf bank_mask:0x1
    s_nop 1
    v_add_f32_dpp v31, v34, v31 row_shl:8 row_mask:0xf bank_mask:0x1
    s_nop 1
    v_add_f32_dpp v31, v35, v31 row_shl:12 row_mask:0xf bank_mask:0x1
    s_waitcnt vmcnt(5)
    buffer_load_dwordx4 v[156:159], v1, s[16:19], s29 offen offset:256 nt
    v_add_f32_dpp v31, v36, v38 row_shr:8 row_mask:0xf bank_mask:0x4
    s_nop 1
    v_add_f32_dpp v31, v37, v31 row_shr:4 row_mask:0xf bank_mask:0x4
    s_nop 1
    v_add_f32_dpp v31, v39, v31 row_shl:4 row_mask:0xf bank_mask:0x4
    s_nop 1
    v_mov_b32_dpp v31, v31 row_shr:4 row_mask:0xf bank_mask:0xa
    ds_write_b128 v7, v[28:31]
    v_add_u32 v7, 1024, v7
    v_max3_f32 v5, v5, v28, v29
    v_max3_f32 v5, v5, v30, v31
L_kmid:
    s_waitcnt vmcnt(5)
    buffer_load_dwordx4 v[160:163], v1, s[16:19], s29 offen offset:512 nt
    s_add_u32 s29, s29, 12288
    s_cmp_eq_u32 s29, 786432
    s_cselect_b32 s29, 0, s29
    v_mfma_f32_16x16x32_bf16 v[32:35], v[128:131], v[8:11], 0
    v_mfma_f32_16x16x32_bf16 v[32:35], v[132:135], v[12:15], v[32:35]
    v_mfma_f32_16x16x32_bf16 v[36:39], v[132:135], v[16:19], 0
    v_mfma_f32_16x16x32_bf16 v[36:39], v[136:139], v[20:23], v[36:39]
    s_waitcnt vmcnt(4)
    buffer_load_dwordx4 v[164:167], v1, s[16:19], s29 offen offset:0 nt
    s_nop 3
    v_add_f32_dpp v24, v33, v32 row_shl:4 row_mask:0xf bank_mask:0x1
    s_nop 1
    v_add_f32_dpp v24, v34, v24 row_shl:8 row_mask:0xf bank_mask:0x1
    s_nop 1
    v_add_f32_dpp v24, v35, v24 row_shl:12 row_mask:0xf bank_mask:0x1
    s_waitcnt vmcnt(5)
    buffer_load_dwordx4 v[168:171], v1, s[16:19], s29 offen offset:256 nt
    v_add_f32_dpp v24, v36, v38 row_shr:8 row_mask:0xf bank_mask:0x4
    s_nop 1
    v_add_f32_dpp v24, v37, v24 row_shr:4 row_mask:0xf bank_mask:0x4
    s_nop 1
    v_add_f32_dpp v24, v39, v24 row_shl:4 row_mask:0xf bank_mask:0x4
    s_nop 1
    v_mov_b32_dpp v24, v24 row_shr:4 row_mask:0xf bank_mask:0xa
    s_waitcnt vmcnt(5)
    buffer_load_dwordx4 v[172:175], v1, s[16:19], s29 offen offset:512 nt
    s_add_u32 s29, s29, 12288
    s_cmp_eq_u32 s29, 786432
    s_cselect_b32 s29, 0, s29
    v_mfma_f32_16x16x32_bf16 v[32:35], v[140:143], v[8:11], 0
    v_mfma_f32_16x16x32_bf16 v[32:35], v[144:147], v[12:15], v[32:35]
    v_mfma_f32_16x16x32_bf16 v[36:39], v[144:147], v[16:19], 0
    v_mfma_f32_16x16x32_bf16 v[36:39], v[148:151], v[20:23], v[36:39]
    s_waitcnt vmcnt(4)
    buffer_load_dwordx4 v[176:179], v1, s[16:19], s29 offen offset:0 nt
    s_nop 3
    v_add_f32_dpp v25, v33, v32 row_shl:4 row_mask:0xf bank_mask:0x1
    s_nop 1
    v_add_f32_dpp v25, v34, v25 row_shl:8 row_mask:0xf bank_mask:0x1
    s_nop 1
    v_add_f32_dpp v25, v35, v25 row_shl:12 row_mask:0xf bank_mask:0x1
    s_waitcnt vmcnt(5)
    buffer_load_dwordx4 v[180:183], v1, s[16:19], s29 offen offset:256 nt
    v_add_f32_dpp v25, v36, v38 row_shr:8 row_mask:0xf bank_mask:0x4
    s_nop 1
    v_add_f32_dpp v25, v37, v25 row_shr:4 row_mask:0xf bank_mask:0x4
    s_nop 1
    v_add_f32_dpp v25, v39, v25 row_shl:4 row_mask:0xf bank_mask:0x4
    s_nop 1
    v_mov_b32_dpp v25, v25 row_shr:4 row_mask:0xf bank_mask:0xa
    s_waitcnt vmcnt(5)
    buffer_load_dwordx4 v[184:187], v1, s[16:19], s29 offen offset:512 nt
    s_add_u32 s29, s29, 12288
    s_cmp_eq_u32 s29, 786432
    s_cselect_b32 s29, 0, s29
    v_mfma_f32_16x16x32_bf16 v[32:35], v[152:155], v[8:11], 0
    v_mfma_f32_16x16x32_bf16 v[32:35], v[156:159], v[12:15], v[32:35]
    v_mfma_f32_16x16x32_bf16 v[36:39], v[156:159], v[16:19], 0
    v_mfma_f32_16x16x32_bf16 v[36:39], v[160:163], v[20:23], v[36:39]
    s_waitcnt vmcnt(4)
    buffer_load_dwordx4 v[188:191], v1, s[16:19], s29 offen offset:0 nt
    s_nop 3
    v_add_f32_dpp v26, v33, v32 row_shl:4 row_mask:0xf bank_mask:0x1
    s_nop 1
    v_add_f32_dpp v26, v34, v26 row_shl:8 row_mask:0xf bank_mask:0x1
    s_nop 1
    v_add_f32_dpp v26, v35, v26 row_shl:12 row_mask:0xf bank_mask:0x1
    s_waitcnt vmcnt(5)
    buffer_load_dwordx4 v[192:195], v1, s[16:19], s29 offen offset:256 nt
    v_add_f32_dpp v26, v36, v38 row_shr:8 row_mask:0xf bank_mask:0x4
    s_nop 1
    v_add_f32_dpp v26, v37, v26 row_shr:4 row_mask:0xf bank_mask:0x4
    s_nop 1
    v_add_f32_dpp v26, v39, v26 row_shl:4 row_mask:0xf bank_mask:0x4
    s_nop 1
    v_mov_b32_dpp v26, v26 row_shr:4 row_mask:0xf bank_mask:0xa
    s_waitcnt vmcnt(5)
    buffer_load_dwordx4 v[196:199], v1, s[16:19], s29 offen offset:512 nt
    s_add_u32 s29, s29, 12288
    s_cmp_eq_u32 s29, 786432
    s_cselect_b32 s29, 0, s29
    v_mfma_f32_16x16x32_bf16 v[32:35], v[164:167], v[8:11], 0
    v_mfma_f32_16x16x32_bf16 v[32:35], v[168:171], v[12:15], v[32:35]
    v_mfma_f32_16x16x32_bf16 v[36:39], v[168:171], v[16:19], 0
    v_mfma_f32_16x16x32_bf16 v[36:39], v[172:175], v[20:23], v[36:39]
    s_waitcnt vmcnt(4)
    buffer_load_dwordx4 v[200:203], v1, s[16:19], s29 offen offset:0 nt
    s_nop 3
    v_add_f32_dpp v27, v33, v32 row_shl:4 row_mask:0xf bank_mask:0x1
    s_nop 1
    v_add_f32_dpp v27, v34, v27 row_shl:8 row_mask:0xf bank_mask:0x1
    s_nop 1
    v_add_f32_dpp v27, v35, v27 row_shl:12 row_mask:0xf bank_mask:0x1
    s_waitcnt vmcnt(5)
    buffer_load_dwordx4 v[204:207], v1, s[16:19], s29 offen offset:256 nt
    v_add_f32_dpp v27, v36, v38 row_shr:8 row_mask:0xf bank_mask:0x4
    s_nop 1
    v_add_f32_dpp v27, v37, v27 row_shr:4 row_mask:0xf bank_mask:0x4
    s_nop 1
    v_add_f32_dpp v27, v39, v27 row_shl:4 row_mask:0xf bank_mask:0x4
    s_nop 1
    v_mov_b32_dpp v27, v27 row_shr:4 row_mask:0xf bank_mask:0xa
    ds_write_b128 v7, v[24:27]
    v_add_u32 v7, 1024, v7
    v_max3_f32 v5, v5, v24, v25
    v_max3_f32 v5, v5, v26, v27
    s_waitcnt vmcnt(5)
    buffer_load_dwordx4 v[208:211], v1, s[16:19], s29 offen offset:512 nt
    s_add_u32 s29, s29, 12288
    s_cmp_eq_u32 s29, 786432
    s_cselect_b32 s29, 0, s29
    v_mfma_f32_16x16x32_bf16 v[32:35], v[176:179], v[8:11], 0
    v_mfma_f32_16x16x32_bf16 v[32:35], v[180:183], v[12:15], v[32:35]
    v_mfma_f32_16x16x32_bf16 v[36:39], v[180:183], v[16:19], 0
    v_mfma_f32_16x16x32_bf16 v[36:39], v[184:187], v[20:23], v[36:39]
    s_waitcnt vmcnt(4)
    buffer_load_dwordx4 v[212:215], v1, s[16:19], s29 offen offset:0 nt
    s_nop 3
    v_add_f32_dpp v28, v33, v32 row_shl:4 row_mask:0xf bank_mask:0x1
    s_nop 1
    v_add_f32_dpp v28, v34, v28 row_shl:8 row_mask:0xf bank_mask:0x1
    s_nop 1
    v_add_f32_dpp v28, v35, v28 row_shl:12 row_mask:0xf bank_mask:0x1
    s_waitcnt vmcnt(5)
    buffer_load_dwordx4 v[216:219], v1, s[16:19], s29 offen offset:256 nt
    v_add_f32_dpp v28, v36, v38 row_shr:8 row_mask:0xf bank_mask:0x4
    s_nop 1
    v_add_f32_dpp v28, v37, v28 row_shr:4 row_mask:0xf bank_mask:0x4
    s_nop 1
    v_add_f32_dpp v28, v39, v28 row_shl:4 row_mask:0xf bank_mask:0x4
    s_nop 1
    v_mov_b32_dpp v28, v28 row_shr:4 row_mask:0xf bank_mask:0xa
    s_waitcnt vmcnt(5)
    buffer_load_dwordx4 v[220:223], v1, s[16:19], s29 offen offset:512 nt
    s_add_u32 s29, s29, 12288
    s_cmp_eq_u32 s29, 786432
    s_cselect_b32 s29, 0, s29
    v_mfma_f32_16x16x32_bf16 v[32:35], v[188:191], v[8:11], 0
    v_mfma_f32_16x16x32_bf16 v[32:35], v[192:195], v[12:15], v[32:35]
    v_mfma_f32_16x16x32_bf16 v[36:39], v[192:195], v[16:19], 0
    v_mfma_f32_16x16x32_bf16 v[36:39], v[196:199], v[20:23], v[36:39]
    s_sub_u32 s34, s34, 1
    s_cmp_lg_u32 s34, 0
    s_cbranch_scc1 L_kloop
    s_waitcnt vmcnt(4)
    buffer_load_dwordx4 v[128:131], v2, s[20:23], s30 offen offset:0 nt
    s_nop 3
    v_add_f32_dpp v29, v33, v32 row_shl:4 row_mask:0xf bank_mask:0x1
    s_nop 1
    v_add_f32_dpp v29, v34, v29 row_shl:8 row_mask:0xf bank_mask:0x1
    s_nop 1
    v_add_f32_dpp v29, v35, v29 row_shl:12 row_mask:0xf bank_mask:0x1
    s_waitcnt vmcnt(5)
    buffer_load_dwordx4 v[132:135], v2, s[20:23], s30 offen offset:256 nt
    v_add_f32_dpp v29, v36, v38 row_shr:8 row_mask:0xf bank_mask:0x4
    s_nop 1
    v_add_f32_dpp v29, v37, v29 row_shr:4 row_mask:0xf bank_mask:0x4
    s_nop 1
    v_add_f32_dpp v29, v39, v29 row_shl:4 row_mask:0xf bank_mask:0x4
    s_nop 1
    v_mov_b32_dpp v29, v29 row_shr:4 row_mask:0xf bank_mask:0xa
    s_waitcnt vmcnt(5)
    buffer_load_dwordx4 v[136:139], v2, s[20:23], s30 offen offset:512 nt
    s_add_u32 s30, s30, 12288
    s_cmp_eq_u32 s30, 786432
    s_cselect_b32 s30, 0, s30
    v_mfma_f32_16x16x32_bf16 v[32:35], v[200:203], v[8:11], 0
    v_mfma_f32_16x16x32_bf16 v[32:35], v[204:207], v[12:15], v[32:35]
    v_mfma_f32_16x16x32_bf16 v[36:39], v[204:207], v[16:19], 0
    v_mfma_f32_16x16x32_bf16 v[36:39], v[208:211], v[20:23], v[36:39]
    s_waitcnt vmcnt(4)
    buffer_load_dwordx4 v[140:143], v2, s[20:23], s30 offen offset:0 nt
    s_nop 3
    v_add_f32_dpp v30, v33, v32 row_shl:4 row_mask:0xf bank_mask:0x1
    s_nop 1
    v_add_f32_dpp v30, v34, v30 row_shl:8 row_mask:0xf bank_mask:0x1
    s_nop 1
    v_add_f32_dpp v30, v35, v30 row_shl:12 row_mask:0xf bank_mask:0x1
    s_waitcnt vmcnt(5)
    buffer_load_dwordx4 v[144:147], v2, s[20:23], s30 offen offset:256 nt
    v_add_f32_dpp v30, v36, v38 row_shr:8 row_mask:0xf bank_mask:0x4
    s_nop 1
    v_add_f32_dpp v30, v37, v30 row_shr:4 row_mask:0xf bank_mask:0x4
    s_nop 1
    v_add_f32_dpp v30, v39, v30 row_shl:4 row_mask:0xf bank_mask:0x4
    s_nop 1
    v_mov_b32_dpp v30, v30 row_shr:4 row_mask:0xf bank_mask:0xa
    s_waitcnt vmcnt(5)
    buffer_load_dwordx4 v[148:151], v2, s[20:23], s30 offen offset:512 nt
    s_add_u32 s30, s30, 12288
    s_cmp_eq_u32 s30, 786432
    s_cselect_b32 s30, 0, s30
    v_mfma_f32_16x16x32_bf16 v[32:35], v[212:215], v[8:11], 0
    v_mfma_f32_16x16x32_bf16 v[32:35], v[216:219], v[12:15], v[32:35]
    v_mfma_f32_16x16x32_bf16 v[36:39], v[216:219], v[16:19], 0
    v_mfma_f32_16x16x32_bf16 v[36:39], v[220:223], v[20:23], v[36:39]
    s_waitcnt vmcnt(4)
    buffer_load_dwordx4 v[152:155], v2, s[20:23], s30 offen offset:0 nt
    s_nop 3
    v_add_f32_dpp v31, v33, v32 row_shl:4 row_mask:0xf bank_mask:0x1
    s_nop 1
    v_add_f32_dpp v31, v34, v31 row_shl:8 row_mask:0xf bank_mask:0x1
    s_nop 1
    v_add_f32_dpp v31, v35, v31 row_shl:12 row_mask:0xf bank_mask:0x1
    s_waitcnt vmcnt(5)
    buffer_load_dwordx4 v[156:159], v2, s[20:23], s30 offen offset:256 nt
    v_add_f32_dpp v31, v36, v38 row_shr:8 row_mask:0xf bank_mask:0x4
    s_nop 1
    v_add_f32_dpp v31, v37, v31 row_shr:4 row_mask:0xf bank_mask:0x4
    s_nop 1
    v_add_f32_dpp v31, v39, v31 row_shl:4 row_mask:0xf bank_mask:0x4
    s_nop 1
    v_mov_b32_dpp v31, v31 row_shr:4 row_mask:0xf bank_mask:0xa
    ds_write_b128 v7, v[28:31]
    v_add_u32 v7, 1024, v7
    v_max3_f32 v5, v5, v28, v29
    v_max3_f32 v5, v5, v30, v31
    s_waitcnt vmcnt(5)
    buffer_load_dwordx4 v[160:163], v2, s[20:23], s30 offen offset:512 nt
    s_add_u32 s30, s30, 12288
    s_cmp_eq_u32 s30, 786432
    s_cselect_b32 s30, 0, s30
    v_max_f32_dpp v5, v5, v5 row_ror:8 row_mask:0xf bank_mask:0xf
    v_mov_b32 v49, v5
    s_nop 1
    v_permlane16_swap_b32 v5, v49
    s_waitcnt vmcnt(4)
    buffer_load_dwordx4 v[164:167], v2, s[20:23], s30 offen offset:0 nt
    v_max_f32 v5, v5, v49
    v_mov_b32 v49, v5
    s_nop 1
    v_permlane32_swap_b32 v5, v49
    s_waitcnt vmcnt(5)
    buffer_load_dwordx4 v[168:171], v2, s[20:23], s30 offen offset:256 nt
    v_max_f32 v5, v5, v49
    v_mul_f32 v46, s35, v5
    s_mov_b32 s34, 7
L_vloop:
    s_waitcnt vmcnt(5)
    buffer_load_dwordx4 v[172:175], v2, s[20:23], s30 offen offset:512 nt
    s_add_u32 s30, s30, 12288
    s_cmp_eq_u32 s30, 786432
    s_cselect_b32 s30, 0, s30
    ds_read_b128 v[24:27], v62 offset:0
    s_waitcnt vmcnt(4)
    buffer_load_dwordx4 v[176:179], v2, s[20:23], s30 offen offset:0 nt
    s_waitcnt lgkmcnt(0)
    v_fma_f32 v24, v24, s35, -v46
    v_fma_f32 v25, v25, s35, -v46
    v_fma_f32 v26, v26, s35, -v46
    v_fma_f32 v27, v27, s35, -v46
    v_exp_f32 v24, v24
    v_exp_f32 v25, v25
    v_exp_f32 v26, v26
    v_exp_f32 v27, v27
    s_waitcnt vmcnt(5)
    buffer_load_dwordx4 v[180:183], v2, s[20:23], s30 offen offset:256 nt
    v_cvt_pk_bf16_f32 v40, v24, v25
    v_cvt_pk_bf16_f32 v41, v26, v27
    v_add_f32 v48, v24, v25
    v_add_f32 v49, v26, v27
    v_add_f32 v48, v48, v49
    v_add_f32 v6, v6, v48
    s_waitcnt vmcnt(5)
    buffer_load_dwordx4 v[184:187], v2, s[20:23], s30 offen offset:512 nt
    s_add_u32 s30, s30, 12288
    s_cmp_eq_u32 s30, 786432
    s_cselect_b32 s30, 0, s30
    v_and_b32 v42, v40, v3
    v_and_b32 v44, v40, v4
    v_and_b32 v43, v41, v3
    v_and_b32 v45, v41, v4
    s_waitcnt vmcnt(4)
    buffer_load_dwordx4 v[188:191], v2, s[20:23], s30 offen offset:0 nt
    s_waitcnt vmcnt(5)
    buffer_load_dwordx4 v[192:195], v2, s[20:23], s30 offen offset:256 nt
    s_waitcnt vmcnt(5)
    buffer_load_dwordx4 v[196:199], v2, s[20:23], s30 offen offset:512 nt
    s_add_u32 s30, s30, 12288
    s_cmp_eq_u32 s30, 786432
    s_cselect_b32 s30, 0, s30
    v_perm_b32 v64, v140, v128, s36
    v_perm_b32 v65, v164, v152, s36
    v_perm_b32 v66, v142, v130, s36
    v_perm_b32 v67, v166, v154, s36
    v_perm_b32 v68, v140, v128, s37
    v_perm_b32 v69, v164, v152, s37
    v_perm_b32 v70, v142, v130, s37
    v_perm_b32 v71, v166, v154, s37
    v_mfma_f32_16x16x32_bf16 v[80:83], v[42:45], v[64:67], v[80:83]
    s_nop 0
    v_mfma_f32_16x16x32_bf16 v[84:87], v[42:45], v[68:71], v[84:87]
    s_waitcnt vmcnt(4)
    buffer_load_dwordx4 v[200:203], v2, s[20:23], s30 offen offset:0 nt
    v_perm_b32 v72, v141, v129, s36
    v_perm_b32 v73, v165, v153, s36
    v_perm_b32 v74, v143, v131, s36
    v_perm_b32 v75, v167, v155, s36
    v_perm_b32 v76, v141, v129, s37
    v_perm_b32 v77, v165, v153, s37
    v_perm_b32 v78, v143, v131, s37
    v_perm_b32 v79, v167, v155, s37
    v_mfma_f32_16x16x32_bf16 v[88:91], v[42:45], v[72:75], v[88:91]
    s_nop 0
    v_mfma_f32_16x16x32_bf16 v[92:95], v[42:45], v[76:79], v[92:95]
    s_waitcnt vmcnt(5)
    buffer_load_dwordx4 v[204:207], v2, s[20:23], s30 offen offset:256 nt
    v_perm_b32 v64, v144, v132, s36
    v_perm_b32 v65, v168, v156, s36
    v_perm_b32 v66, v146, v134, s36
    v_perm_b32 v67, v170, v158, s36
    v_perm_b32 v68, v144, v132, s37
    v_perm_b32 v69, v168, v156, s37
    v_perm_b32 v70, v146, v134, s37
    v_perm_b32 v71, v170, v158, s37
    v_mfma_f32_16x16x32_bf16 v[96:99], v[42:45], v[64:67], v[96:99]
    s_nop 0
    v_mfma_f32_16x16x32_bf16 v[100:103], v[42:45], v[68:71], v[100:103]
    s_waitcnt vmcnt(5)
    buffer_load_dwordx4 v[208:211], v2, s[20:23], s30 offen offset:512 nt
    s_add_u32 s30, s30, 12288
    s_cmp_eq_u32 s30, 786432
    s_cselect_b32 s30, 0, s30
    v_perm_b32 v72, v145, v133, s36
    v_perm_b32 v73, v169, v157, s36
    v_perm_b32 v74, v147, v135, s36
    v_perm_b32 v75, v171, v159, s36
    v_perm_b32 v76, v145, v133, s37
    v_perm_b32 v77, v169, v157, s37
    v_perm_b32 v78, v147, v135, s37
    v_perm_b32 v79, v171, v159, s37
    v_mfma_f32_16x16x32_bf16 v[104:107], v[42:45], v[72:75], v[104:107]
    s_nop 0
    v_mfma_f32_16x16x32_bf16 v[108:111], v[42:45], v[76:79], v[108:111]
    s_waitcnt vmcnt(4)
    buffer_load_dwordx4 v[212:215], v2, s[20:23], s30 offen offset:0 nt
    v_perm_b32 v64, v148, v136, s36
    v_perm_b32 v65, v172, v160, s36
    v_perm_b32 v66, v150, v138, s36
    v_perm_b32 v67, v174, v162, s36
    v_perm_b32 v68, v148, v136, s37
    v_perm_b32 v69, v172, v160, s37
    v_perm_b32 v70, v150, v138, s37
    v_perm_b32 v71, v174, v162, s37
    v_mfma_f32_16x16x32_bf16 v[112:115], v[42:45], v[64:67], v[112:115]
    s_nop 0
    v_mfma_f32_16x16x32_bf16 v[116:119], v[42:45], v[68:71], v[116:119]
    s_waitcnt vmcnt(5)
    buffer_load_dwordx4 v[216:219], v2, s[20:23], s30 offen offset:256 nt
    v_perm_b32 v72, v149, v137, s36
    v_perm_b32 v73, v173, v161, s36
    v_perm_b32 v74, v151, v139, s36
    v_perm_b32 v75, v175, v163, s36
    v_perm_b32 v76, v149, v137, s37
    v_perm_b32 v77, v173, v161, s37
    v_perm_b32 v78, v151, v139, s37
    v_perm_b32 v79, v175, v163, s37
    v_mfma_f32_16x16x32_bf16 v[120:123], v[42:45], v[72:75], v[120:123]
    s_nop 0
    v_mfma_f32_16x16x32_bf16 v[124:127], v[42:45], v[76:79], v[124:127]
    s_waitcnt vmcnt(5)
    buffer_load_dwordx4 v[220:223], v2, s[20:23], s30 offen offset:512 nt
    s_add_u32 s30, s30, 12288
    s_cmp_eq_u32 s30, 786432
    s_cselect_b32 s30, 0, s30
    ds_read_b128 v[24:27], v62 offset:1024
    v_add_u32 v62, 2048, v62
    s_waitcnt vmcnt(4)
    buffer_load_dwordx4 v[128:131], v2, s[20:23], s30 offen offset:0 nt
    s_waitcnt lgkmcnt(0)
    v_fma_f32 v24, v24, s35, -v46
    v_fma_f32 v25, v25, s35, -v46
    v_fma_f32 v26, v26, s35, -v46
    v_fma_f32 v27, v27, s35, -v46
    v_exp_f32 v24, v24
    v_exp_f32 v25, v25
    v_exp_f32 v26, v26
    v_exp_f32 v27, v27
    s_waitcnt vmcnt(5)
    buffer_load_dwordx4 v[132:135], v2, s[20:23], s30 offen offset:256 nt
    v_cvt_pk_bf16_f32 v40, v24, v25
    v_cvt_pk_bf16_f32 v41, v26, v27
    v_add_f32 v48, v24, v25
    v_add_f32 v49, v26, v27
    v_add_f32 v48, v48, v49
    v_add_f32 v6, v6, v48
    s_waitcnt vmcnt(5)
    buffer_load_dwordx4 v[136:139], v2, s[20:23], s30 offen offset:512 nt
    s_add_u32 s30, s30, 12288
    s_cmp_eq_u32 s30, 786432
    s_cselect_b32 s30, 0, s30
    v_and_b32 v42, v40, v3
    v_and_b32 v44, v40, v4
    v_and_b32 v43, v41, v3
    v_and_b32 v45, v41, v4
    s_waitcnt vmcnt(4)
    buffer_load_dwordx4 v[140:143], v2, s[20:23], s30 offen offset:0 nt
    s_waitcnt vmcnt(5)
    buffer_load_dwordx4 v[144:147], v2, s[20:23], s30 offen offset:256 nt
    s_waitcnt vmcnt(5)
    buffer_load_dwordx4 v[148:151], v2, s[20:23], s30 offen offset:512 nt
    s_add_u32 s30, s30, 12288
    s_cmp_eq_u32 s30, 786432
    s_cselect_b32 s30, 0, s30
    v_perm_b32 v64, v188, v176, s36
    v_perm_b32 v65, v212, v200, s36
    v_perm_b32 v66, v190, v178, s36
    v_perm_b32 v67, v214, v202, s36
    v_perm_b32 v68, v188, v176, s37
    v_perm_b32 v69, v212, v200, s37
    v_perm_b32 v70, v190, v178, s37
    v_perm_b32 v71, v214, v202, s37
    v_mfma_f32_16x16x32_bf16 v[80:83], v[42:45], v[64:67], v[80:83]
    s_nop 0
    v_mfma_f32_16x16x32_bf16 v[84:87], v[42:45], v[68:71], v[84:87]
    s_waitcnt vmcnt(4)
    buffer_load_dwordx4 v[152:155], v2, s[20:23], s30 offen offset:0 nt
    v_perm_b32 v72, v189, v177, s36
    v_perm_b32 v73, v213, v201, s36
    v_perm_b32 v74, v191, v179, s36
    v_perm_b32 v75, v215, v203, s36
    v_perm_b32 v76, v189, v177, s37
    v_perm_b32 v77, v213, v201, s37
    v_perm_b32 v78, v191, v179, s37
    v_perm_b32 v79, v215, v203, s37
    v_mfma_f32_16x16x32_bf16 v[88:91], v[42:45], v[72:75], v[88:91]
    s_nop 0
    v_mfma_f32_16x16x32_bf16 v[92:95], v[42:45], v[76:79], v[92:95]
    s_waitcnt vmcnt(5)
    buffer_load_dwordx4 v[156:159], v2, s[20:23], s30 offen offset:256 nt
    v_perm_b32 v64, v192, v180, s36
    v_perm_b32 v65, v216, v204, s36
    v_perm_b32 v66, v194, v182, s36
    v_perm_b32 v67, v218, v206, s36
    v_perm_b32 v68, v192, v180, s37
    v_perm_b32 v69, v216, v204, s37
    v_perm_b32 v70, v194, v182, s37
    v_perm_b32 v71, v218, v206, s37
    v_mfma_f32_16x16x32_bf16 v[96:99], v[42:45], v[64:67], v[96:99]
    s_nop 0
    v_mfma_f32_16x16x32_bf16 v[100:103], v[42:45], v[68:71], v[100:103]
    s_waitcnt vmcnt(5)
    buffer_load_dwordx4 v[160:163], v2, s[20:23], s30 offen offset:512 nt
    s_add_u32 s30, s30, 12288
    s_cmp_eq_u32 s30, 786432
    s_cselect_b32 s30, 0, s30
    v_perm_b32 v72, v193, v181, s36
    v_perm_b32 v73, v217, v205, s36
    v_perm_b32 v74, v195, v183, s36
    v_perm_b32 v75, v219, v207, s36
    v_perm_b32 v76, v193, v181, s37
    v_perm_b32 v77, v217, v205, s37
    v_perm_b32 v78, v195, v183, s37
    v_perm_b32 v79, v219, v207, s37
    v_mfma_f32_16x16x32_bf16 v[104:107], v[42:45], v[72:75], v[104:107]
    s_nop 0
    v_mfma_f32_16x16x32_bf16 v[108:111], v[42:45], v[76:79], v[108:111]
    s_waitcnt vmcnt(4)
    buffer_load_dwordx4 v[164:167], v2, s[20:23], s30 offen offset:0 nt
    v_perm_b32 v64, v196, v184, s36
    v_perm_b32 v65, v220, v208, s36
    v_perm_b32 v66, v198, v186, s36
    v_perm_b32 v67, v222, v210, s36
    v_perm_b32 v68, v196, v184, s37
    v_perm_b32 v69, v220, v208, s37
    v_perm_b32 v70, v198, v186, s37
    v_perm_b32 v71, v222, v210, s37
    v_mfma_f32_16x16x32_bf16 v[112:115], v[42:45], v[64:67], v[112:115]
    s_nop 0
    v_mfma_f32_16x16x32_bf16 v[116:119], v[42:45], v[68:71], v[116:119]
    s_waitcnt vmcnt(5)
    buffer_load_dwordx4 v[168:171], v2, s[20:23], s30 offen offset:256 nt
    v_perm_b32 v72, v197, v185, s36
    v_perm_b32 v73, v221, v209, s36
    v_perm_b32 v74, v199, v187, s36
    v_perm_b32 v75, v223, v211, s36
    v_perm_b32 v76, v197, v185, s37
    v_perm_b32 v77, v221, v209, s37
    v_perm_b32 v78, v199, v187, s37
    v_perm_b32 v79, v223, v211, s37
    v_mfma_f32_16x16x32_bf16 v[120:123], v[42:45], v[72:75], v[120:123]
    s_nop 0
    v_mfma_f32_16x16x32_bf16 v[124:127], v[42:45], v[76:79], v[124:127]
    s_sub_u32 s34, s34, 1
    s_cmp_lg_u32 s34, 0
    s_cbranch_scc1 L_vloop
    ds_read_b128 v[24:27], v62
    ds_read_b128 v[28:31], v62 offset:1024
    s_waitcnt vmcnt(11)
    buffer_load_dwordx4 v[172:175], v2, s[20:23], s30 offen offset:512 nt
    s_add_u32 s30, s30, 12288
    s_cmp_eq_u32 s30, 786432
    s_cselect_b32 s30, 0, s30
    s_waitcnt lgkmcnt(1)
    v_fma_f32 v24, v24, s35, -v46
    v_fma_f32 v25, v25, s35, -v46
    v_fma_f32 v26, v26, s35, -v46
    v_fma_f32 v27, v27, s35, -v46
    v_exp_f32 v24, v24
    v_exp_f32 v25, v25
    v_exp_f32 v26, v26
    v_exp_f32 v27, v27
    s_mov_b32 s42, s30
    s_add_u32 s43, s42, 12288
    s_cmp_eq_u32 s43, 786432
    s_cselect_b32 s43, 0, s43
    s_add_u32 s44, s43, 12288
    s_cmp_eq_u32 s44, 786432
    s_cselect_b32 s44, 0, s44
    s_add_u32 s45, s44, 12288
    s_cmp_eq_u32 s45, 786432
    s_cselect_b32 s45, 0, s45
    s_waitcnt vmcnt(11)
    buffer_load_dwordx4 v[176:179], v2, s[20:23], s42 offen offset:0 nt
    v_cvt_pk_bf16_f32 v40, v24, v25
    v_cvt_pk_bf16_f32 v41, v26, v27
    v_add_f32 v48, v24, v25
    v_add_f32 v49, v26, v27
    v_add_f32 v48, v48, v49
    v_add_f32 v6, v6, v48
    v_and_b32 v42, v40, v3
    v_and_b32 v44, v40, v4
    v_and_b32 v43, v41, v3
    v_and_b32 v45, v41, v4
    s_waitcnt lgkmcnt(0)
    v_fma_f32 v28, v28, s35, -v46
    v_fma_f32 v29, v29, s35, -v46
    v_fma_f32 v30, v30, s35, -v46
    v_fma_f32 v31, v31, s35, -v46
    v_exp_f32 v28, v28
    v_exp_f32 v29, v29
    v_exp_f32 v30, v30
    v_exp_f32 v31, v31
    s_waitcnt vmcnt(11)
    buffer_load_dwordx4 v[180:183], v2, s[20:23], s42 offen offset:256 nt
    v_cvt_pk_bf16_f32 v40, v28, v29
    v_cvt_pk_bf16_f32 v41, v30, v31
    v_add_f32 v48, v28, v29
    v_add_f32 v49, v30, v31
    v_add_f32 v48, v48, v49
    v_add_f32 v6, v6, v48
    v_and_b32 v32, v40, v3
    v_and_b32 v34, v40, v4
    v_and_b32 v33, v41, v3
    v_and_b32 v35, v41, v4
    v_add_f32_dpp v6, v6, v6 row_ror:8 row_mask:0xf bank_mask:0xf
    v_mov_b32 v49, v6
    s_nop 1
    v_permlane16_swap_b32 v6, v49
    s_nop 1
    v_add_f32 v6, v6, v49
    s_waitcnt vmcnt(11)
    buffer_load_dwordx4 v[188:191], v2, s[20:23], s43 offen offset:0 nt
    v_mov_b32 v49, v6
    s_nop 1
    v_permlane32_swap_b32 v6, v49
    s_nop 1
    v_add_f32 v6, v6, v49
    v_and_b32 v50, 3, v0
    v_lshlrev_b32 v50, 4, v50
    s_lshl_b32 s38, s28, 2
    s_add_u32 s38, s38, 65536
    v_add_u32 v50, s38, v50
    ds_write_b32 v50, v5
    ds_write_b32 v50, v6 offset:64
    v_bfe_u32 v8, v0, 3, 1
    v_lshlrev_b32 v8, 1, v8
    v_lshrrev_b32 v9, 5, v0
    v_add_u32 v8, v8, v9
    v_lshlrev_b32 v9, 4, v8
    v_add_u32 v11, s38, v9
    v_add_u32 v9, 65536, v9
    v_mul_u32_u24 v10, 384, v8
    v_and_b32 v12, 7, v0
    v_lshlrev_b32 v12, 4, v12
    v_bfe_u32 v13, v0, 4, 1
    v_lshlrev_b32 v13, 3, v13
    v_add3_u32 v10, v10, v12, v13
    s_lshl_b32 s39, s28, 10
    v_lshlrev_b32 v12, 4, v0
    v_add_u32 v12, s39, v12
    s_lshl_b32 s39, s28, 7
    s_waitcnt vmcnt(11)
    buffer_load_dwordx4 v[192:195], v2, s[20:23], s43 offen offset:256 nt
    s_waitcnt lgkmcnt(0)
    s_barrier
    ds_read_b128 v[16:19], v9
    ds_read_b128 v[20:23], v9 offset:64
    ds_read_b32 v14, v11
    s_waitcnt vmcnt(11)
    buffer_load_dwordx4 v[200:203], v2, s[20:23], s44 offen offset:0 nt
    s_waitcnt lgkmcnt(0)
    v_max_f32 v13, v16, v17
    v_max3_f32 v13, v13, v18, v19
    v_sub_f32 v16, v16, v13
    v_sub_f32 v17, v17, v13
    v_sub_f32 v18, v18, v13
    v_sub_f32 v19, v19, v13
    v_sub_f32 v14, v14, v13
    v_mul_f32 v16, s35, v16
    v_mul_f32 v17, s35, v17
    v_mul_f32 v18, s35, v18
    v_mul_f32 v19, s35, v19
    v_mul_f32 v14, s35, v14
    v_exp_f32 v16, v16
    v_exp_f32 v17, v17
    v_exp_f32 v18, v18
    v_exp_f32 v19, v19
    v_exp_f32 v14, v14
    v_mul_f32 v15, v16, v20
    v_fmac_f32 v15, v17, v21
    v_fmac_f32 v15, v18, v22
    v_fmac_f32 v15, v19, v23
    v_rcp_f32 v15, v15
    s_nop 0
    v_mul_f32 v47, v14, v15
    s_waitcnt vmcnt(11)
    buffer_load_dwordx4 v[204:207], v2, s[20:23], s44 offen offset:256 nt
    s_waitcnt vmcnt(11)
    buffer_load_dwordx4 v[212:215], v2, s[20:23], s45 offen offset:0 nt
    s_waitcnt vmcnt(11)
    buffer_load_dwordx4 v[216:219], v2, s[20:23], s45 offen offset:256 nt
    s_waitcnt vmcnt(11)
    buffer_load_dwordx4 v[184:187], v2, s[20:23], s42 offen offset:512 nt
    s_waitcnt vmcnt(11)
    buffer_load_dwordx4 v[196:199], v2, s[20:23], s43 offen offset:512 nt
    s_waitcnt vmcnt(11)
    buffer_load_dwordx4 v[208:211], v2, s[20:23], s44 offen offset:512 nt
    s_waitcnt vmcnt(11)
    buffer_load_dwordx4 v[220:223], v2, s[20:23], s45 offen offset:512 nt
    v_perm_b32 v64, v140, v128, s36
    v_perm_b32 v65, v164, v152, s36
    v_perm_b32 v66, v142, v130, s36
    v_perm_b32 v67, v166, v154, s36
    v_perm_b32 v68, v140, v128, s37
    v_perm_b32 v69, v164, v152, s37
    v_perm_b32 v70, v142, v130, s37
    v_perm_b32 v71, v166, v154, s37
    v_mfma_f32_16x16x32_bf16 v[80:83], v[42:45], v[64:67], v[80:83]
    s_nop 0
    v_mfma_f32_16x16x32_bf16 v[84:87], v[42:45], v[68:71], v[84:87]
    s_waitcnt vmcnt(12)
    v_perm_b32 v72, v141, v129, s36
    v_perm_b32 v73, v165, v153, s36
    v_perm_b32 v74, v143, v131, s36
    v_perm_b32 v75, v167, v155, s36
    v_perm_b32 v76, v141, v129, s37
    v_perm_b32 v77, v165, v153, s37
    v_perm_b32 v78, v143, v131, s37
    v_perm_b32 v79, v167, v155, s37
    v_mfma_f32_16x16x32_bf16 v[88:91], v[42:45], v[72:75], v[88:91]
    s_nop 0
    v_mfma_f32_16x16x32_bf16 v[92:95], v[42:45], v[76:79], v[92:95]
    v_perm_b32 v64, v144, v132, s36
    v_perm_b32 v65, v168, v156, s36
    v_perm_b32 v66, v146, v134, s36
    v_perm_b32 v67, v170, v158, s36
    v_perm_b32 v68, v144, v132, s37
    v_perm_b32 v69, v168, v156, s37
    v_perm_b32 v70, v146, v134, s37
    v_perm_b32 v71, v170, v158, s37
    v_mfma_f32_16x16x32_bf16 v[96:99], v[42:45], v[64:67], v[96:99]
    s_nop 0
    v_mfma_f32_16x16x32_bf16 v[100:103], v[42:45], v[68:71], v[100:103]
    v_perm_b32 v72, v145, v133, s36
    v_perm_b32 v73, v169, v157, s36
    v_perm_b32 v74, v147, v135, s36
    v_perm_b32 v75, v171, v159, s36
    v_perm_b32 v76, v145, v133, s37
    v_perm_b32 v77, v169, v157, s37
    v_perm_b32 v78, v147, v135, s37
    v_perm_b32 v79, v171, v159, s37
    v_mfma_f32_16x16x32_bf16 v[104:107], v[42:45], v[72:75], v[104:107]
    s_nop 0
    v_mfma_f32_16x16x32_bf16 v[108:111], v[42:45], v[76:79], v[108:111]
    v_perm_b32 v64, v148, v136, s36
    v_perm_b32 v65, v172, v160, s36
    v_perm_b32 v66, v150, v138, s36
    v_perm_b32 v67, v174, v162, s36
    v_perm_b32 v68, v148, v136, s37
    v_perm_b32 v69, v172, v160, s37
    v_perm_b32 v70, v150, v138, s37
    v_perm_b32 v71, v174, v162, s37
    v_mfma_f32_16x16x32_bf16 v[112:115], v[42:45], v[64:67], v[112:115]
    s_nop 0
    v_mfma_f32_16x16x32_bf16 v[116:119], v[42:45], v[68:71], v[116:119]
    v_perm_b32 v72, v149, v137, s36
    v_perm_b32 v73, v173, v161, s36
    v_perm_b32 v74, v151, v139, s36
    v_perm_b32 v75, v175, v163, s36
    v_perm_b32 v76, v149, v137, s37
    v_perm_b32 v77, v173, v161, s37
    v_perm_b32 v78, v151, v139, s37
    v_perm_b32 v79, v175, v163, s37
    v_mfma_f32_16x16x32_bf16 v[120:123], v[42:45], v[72:75], v[120:123]
    s_nop 0
    v_mfma_f32_16x16x32_bf16 v[124:127], v[42:45], v[76:79], v[124:127]
    s_waitcnt vmcnt(4)
    v_perm_b32 v64, v188, v176, s36
    v_perm_b32 v65, v212, v200, s36
    v_perm_b32 v66, v190, v178, s36
    v_perm_b32 v67, v214, v202, s36
    v_perm_b32 v68, v188, v176, s37
    v_perm_b32 v69, v212, v200, s37
    v_perm_b32 v70, v190, v178, s37
    v_perm_b32 v71, v214, v202, s37
    v_mfma_f32_16x16x32_bf16 v[80:83], v[32:35], v[64:67], v[80:83]
    s_nop 0
    v_mfma_f32_16x16x32_bf16 v[84:87], v[32:35], v[68:71], v[84:87]
    v_perm_b32 v72, v189, v177, s36
    v_perm_b32 v73, v213, v201, s36
    v_perm_b32 v74, v191, v179, s36
    v_perm_b32 v75, v215, v203, s36
    v_perm_b32 v76, v189, v177, s37
    v_perm_b32 v77, v213, v201, s37
    v_perm_b32 v78, v191, v179, s37
    v_perm_b32 v79, v215, v203, s37
    v_mfma_f32_16x16x32_bf16 v[88:91], v[32:35], v[72:75], v[88:91]
    s_nop 0
    v_mfma_f32_16x16x32_bf16 v[92:95], v[32:35], v[76:79], v[92:95]
    v_permlane32_swap_b32 v80, v81
    v_permlane32_swap_b32 v82, v83
    v_permlane32_swap_b32 v84, v85
    v_permlane32_swap_b32 v86, v87
    s_nop 1
    v_permlane32_swap_b32 v88, v89
    v_permlane32_swap_b32 v90, v91
    v_permlane32_swap_b32 v92, v93
    v_permlane32_swap_b32 v94, v95
    s_waitcnt vmcnt(4)
    v_perm_b32 v64, v192, v180, s36
    v_perm_b32 v65, v216, v204, s36
    v_perm_b32 v66, v194, v182, s36
    v_perm_b32 v67, v218, v206, s36
    v_perm_b32 v68, v192, v180, s37
    v_perm_b32 v69, v216, v204, s37
    v_perm_b32 v70, v194, v182, s37
    v_perm_b32 v71, v218, v206, s37
    v_mfma_f32_16x16x32_bf16 v[96:99], v[32:35], v[64:67], v[96:99]
    s_nop 0
    v_mfma_f32_16x16x32_bf16 v[100:103], v[32:35], v[68:71], v[100:103]
    v_perm_b32 v72, v193, v181, s36
    v_perm_b32 v73, v217, v205, s36
    v_perm_b32 v74, v195, v183, s36
    v_perm_b32 v75, v219, v207, s36
    v_perm_b32 v76, v193, v181, s37
    v_perm_b32 v77, v217, v205, s37
    v_perm_b32 v78, v195, v183, s37
    v_perm_b32 v79, v219, v207, s37
    v_mfma_f32_16x16x32_bf16 v[104:107], v[32:35], v[72:75], v[104:107]
    s_nop 0
    v_mfma_f32_16x16x32_bf16 v[108:111], v[32:35], v[76:79], v[108:111]
    v_permlane32_swap_b32 v96, v97
    v_permlane32_swap_b32 v98, v99
    v_permlane32_swap_b32 v100, v101
    v_permlane32_swap_b32 v102, v103
    s_nop 1
    v_permlane32_swap_b32 v104, v105
    v_permlane32_swap_b32 v106, v107
    v_permlane32_swap_b32 v108, v109
    v_permlane32_swap_b32 v110, v111
    v_add_f32_dpp v36, v97, v80 row_ror:8 row_mask:0xf bank_mask:0x3
    v_add_f32_dpp v37, v101, v84 row_ror:8 row_mask:0xf bank_mask:0x3
    v_add_f32_dpp v38, v105, v88 row_ror:8 row_mask:0xf bank_mask:0x3
    v_add_f32_dpp v39, v109, v92 row_ror:8 row_mask:0xf bank_mask:0x3
    v_add_f32_dpp v36, v82, v99 row_ror:8 row_mask:0xf bank_mask:0xc
    v_add_f32_dpp v37, v86, v103 row_ror:8 row_mask:0xf bank_mask:0xc
    v_add_f32_dpp v38, v90, v107 row_ror:8 row_mask:0xf bank_mask:0xc
    v_add_f32_dpp v39, v94, v111 row_ror:8 row_mask:0xf bank_mask:0xc
    v_mul_f32 v24, v36, v47
    v_mul_f32 v25, v37, v47
    v_mul_f32 v26, v38, v47
    v_mul_f32 v27, v39, v47
    ds_write_b128 v63, v[24:27] offset:0
    s_waitcnt vmcnt(0)
    v_perm_b32 v64, v196, v184, s36
    v_perm_b32 v65, v220, v208, s36
    v_perm_b32 v66, v198, v186, s36
    v_perm_b32 v67, v222, v210, s36
    v_perm_b32 v68, v196, v184, s37
    v_perm_b32 v69, v220, v208, s37
    v_perm_b32 v70, v198, v186, s37
    v_perm_b32 v71, v222, v210, s37
    v_mfma_f32_16x16x32_bf16 v[112:115], v[32:35], v[64:67], v[112:115]
    s_nop 0
    v_mfma_f32_16x16x32_bf16 v[116:119], v[32:35], v[68:71], v[116:119]
    v_perm_b32 v72, v197, v185, s36
    v_perm_b32 v73, v221, v209, s36
    v_perm_b32 v74, v199, v187, s36
    v_perm_b32 v75, v223, v211, s36
    v_perm_b32 v76, v197, v185, s37
    v_perm_b32 v77, v221, v209, s37
    v_perm_b32 v78, v199, v187, s37
    v_perm_b32 v79, v223, v211, s37
    v_mfma_f32_16x16x32_bf16 v[120:123], v[32:35], v[72:75], v[120:123]
    s_nop 0
    v_mfma_f32_16x16x32_bf16 v[124:127], v[32:35], v[76:79], v[124:127]
    v_permlane32_swap_b32 v112, v113
    v_permlane32_swap_b32 v114, v115
    v_permlane32_swap_b32 v116, v117
    v_permlane32_swap_b32 v118, v119
    s_nop 1
    v_permlane32_swap_b32 v120, v121
    v_permlane32_swap_b32 v122, v123
    v_permlane32_swap_b32 v124, v125
    v_permlane32_swap_b32 v126, v127
    v_add_f32_dpp v36, v80, v113 row_ror:8 row_mask:0xf bank_mask:0x3
    v_add_f32_dpp v37, v84, v117 row_ror:8 row_mask:0xf bank_mask:0x3
    v_add_f32_dpp v38, v88, v121 row_ror:8 row_mask:0xf bank_mask:0x3
    v_add_f32_dpp v39, v92, v125 row_ror:8 row_mask:0xf bank_mask:0x3
    v_add_f32_dpp v36, v115, v82 row_ror:8 row_mask:0xf bank_mask:0xc
    v_add_f32_dpp v37, v119, v86 row_ror:8 row_mask:0xf bank_mask:0xc
    v_add_f32_dpp v38, v123, v90 row_ror:8 row_mask:0xf bank_mask:0xc
    v_add_f32_dpp v39, v127, v94 row_ror:8 row_mask:0xf bank_mask:0xc
    v_mul_f32 v28, v36, v47
    v_mul_f32 v29, v37, v47
    v_mul_f32 v30, v38, v47
    v_mul_f32 v31, v39, v47
    ds_write_b128 v63, v[28:31] offset:1024
    v_add_f32_dpp v36, v113, v96 row_ror:8 row_mask:0xf bank_mask:0x3
    v_add_f32_dpp v37, v117, v100 row_ror:8 row_mask:0xf bank_mask:0x3
    v_add_f32_dpp v38, v121, v104 row_ror:8 row_mask:0xf bank_mask:0x3
    v_add_f32_dpp v39, v125, v108 row_ror:8 row_mask:0xf bank_mask:0x3
    v_add_f32_dpp v36, v98, v115 row_ror:8 row_mask:0xf bank_mask:0xc
    v_add_f32_dpp v37, v102, v119 row_ror:8 row_mask:0xf bank_mask:0xc
    v_add_f32_dpp v38, v106, v123 row_ror:8 row_mask:0xf bank_mask:0xc
    v_add_f32_dpp v39, v110, v127 row_ror:8 row_mask:0xf bank_mask:0xc
    v_mul_f32 v24, v36, v47
    v_mul_f32 v25, v37, v47
    v_mul_f32 v26, v38, v47
    v_mul_f32 v27, v39, v47
    ds_write_b128 v63, v[24:27] offset:2048
    s_waitcnt lgkmcnt(0)
    s_barrier
    s_cmp_ge_u32 s28, 3
    s_cbranch_scc1 L_fin
    ds_read_b128 v[64:67], v12 offset:0
    ds_read_b128 v[68:71], v12 offset:16384
    ds_read_b128 v[72:75], v12 offset:32768
    ds_read_b128 v[76:79], v12 offset:49152
    s_waitcnt lgkmcnt(2)
    v_add_f32 v64, v64, v68
    v_add_f32 v65, v65, v69
    v_add_f32 v66, v66, v70
    v_add_f32 v67, v67, v71
    s_waitcnt lgkmcnt(0)
    v_add_f32 v72, v72, v76
    v_add_f32 v73, v73, v77
    v_add_f32 v74, v74, v78
    v_add_f32 v75, v75, v79
    v_add_f32 v64, v64, v72
    v_add_f32 v65, v65, v73
    v_add_f32 v66, v66, v74
    v_add_f32 v67, v67, v75
    v_cvt_pk_bf16_f32 v20, v64, v65
    v_cvt_pk_bf16_f32 v21, v66, v67
    buffer_store_dwordx2 v[20:21], v10, s[24:27], s39 offen
L_fin:
L_done:
    s_endpgm
.section .rodata,"a"
.p2align 6
.amdhsa_kernel standalone__mha_softmax__sampling_kernel
  .amdhsa_next_free_vgpr 224
  .amdhsa_next_free_sgpr 48
  .amdhsa_accum_offset 224
  .amdhsa_group_segment_fixed_size 0
  .amdhsa_kernarg_size 48
  .amdhsa_user_sgpr_count 2
  .amdhsa_user_sgpr_kernarg_segment_ptr 1
  .amdhsa_system_sgpr_workgroup_id_x 1
.end_amdhsa_kernel
```
